```python
import torch

def _softmax(x, axis=-1):
    return torch.softmax(x, dim=axis)
def _gelu(x):
    return torch.nn.functional.gelu(x, approximate="tanh")
def _silu(x):
    return torch.nn.functional.silu(x)
def _sigmoid(x):
    return torch.sigmoid(x)
def _layernorm(x, axis=-1, eps=1e-5):
    m = x.mean(dim=axis, keepdim=True)
    v = x.var(dim=axis, keepdim=True, unbiased=False)
    return (x - m) / torch.sqrt(v + eps)
def _scatter_add(tgt, idx, src, axis=0):
    return tgt.clone().index_add_(axis, idx, src)
def _segment_sum(src, seg, n):
    out = torch.zeros((n,) + src.shape[1:], dtype=src.dtype)
    return out.index_add_(0, seg, src)
def _pad(x, pw):
    flat = tuple(v for pair in reversed(pw) for v in pair)
    return torch.nn.functional.pad(x, flat)

kernel_name = 'standalone__gqa_softmax__decode'

def setup_inputs():

    _w = (lambda a: (lambda t: t.to(torch.bfloat16) if t.is_floating_point() else t)(torch.as_tensor(a)))
    B, Hq, Hkv, Sq, Sk, D = 2, 32, 4, 1, 32768, 128
    return {
        "q": _w((lambda *s: torch.randn(*s, dtype=torch.bfloat16) * 0.8)(B, Hq, Sq, D)),
        "k": _w((lambda *s: torch.randn(*s, dtype=torch.bfloat16) * 0.8)(B, Hkv, Sk, D)),
        "v": _w((lambda *s: torch.randn(*s, dtype=torch.bfloat16) * 0.05)(B, Hkv, Sk, D)),
    }

def reference(q, k, v):
    B, Hq, Sq, D = q.shape
    Hkv = k.shape[1]
    rep = Hq // Hkv
    k = (lambda x, n, axis: torch.repeat_interleave(x, n, dim=axis))(k, rep, axis=1)
    v = (lambda x, n, axis: torch.repeat_interleave(x, n, dim=axis))(v, rep, axis=1)
    scale = D ** -0.5
    scores = torch.einsum("bhqd,bhkd->bhqk", q, k) * scale
    p = _softmax(scores, axis=-1)
    return torch.einsum("bhqk,bhkd->bhqd", p, v)
```

```asm
; @launch grid=(256,1,1) block=(512,1,1) lds=33792
.amdgcn_target "amdgcn-amd-amdhsa--gfx950"
.text
.globl standalone__gqa_softmax__decode_kernel
.p2align 8
.type standalone__gqa_softmax__decode_kernel,@function
standalone__gqa_softmax__decode_kernel:
    s_cmpk_ge_u32 s2, 0x100
    s_cbranch_scc1 L_end
    s_load_dwordx2 s[8:9], s[0:1], 8
    v_readfirstlane_b32 s24, v0
    s_and_b32 s25, s2, 7
    s_lshr_b32 s26, s2, 3
    v_and_b32 v5, 48, v0
    v_and_b32 v4, 8, v0
    v_lshl_add_u32 v4, v4, 3, v5
    v_and_b32 v5, 3, v0
    v_lshl_add_u32 v1, v5, 10, v4
    v_and_b32 v5, 4, v0
    v_lshl_add_u32 v1, v5, 6, v1
    s_lshl_b32 s40, s25, 23
    s_lshl_b32 s31, s26, 18
    s_lshl_b32 s32, s24, 9
    s_add_u32 s40, s40, s31
    s_add_u32 s40, s40, s32
    s_movk_i32 s31, 0x1000
    s_add_u32 s41, s40, s31
    s_add_u32 s42, s41, s31
    s_add_u32 s43, s42, s31
    s_add_u32 s44, s43, s31
    s_add_u32 s45, s44, s31
    s_add_u32 s46, s45, s31
    s_add_u32 s47, s46, s31
    s_lshl_b32 s10, 1, 26
    s_mov_b32 s11, 0x20000
    s_setprio 3
    s_waitcnt lgkmcnt(0)
    buffer_load_dwordx4 v[56:59], v1, s[8:11], s40 offen offset:0 nt
    buffer_load_dwordx4 v[60:63], v1, s[8:11], s40 offen offset:128 nt
    buffer_load_dwordx4 v[64:67], v1, s[8:11], s40 offen offset:512 nt
    buffer_load_dwordx4 v[68:71], v1, s[8:11], s40 offen offset:640 nt
    buffer_load_dwordx4 v[72:75], v1, s[8:11], s41 offen offset:0 nt
    buffer_load_dwordx4 v[76:79], v1, s[8:11], s41 offen offset:128 nt
    buffer_load_dwordx4 v[80:83], v1, s[8:11], s41 offen offset:512 nt
    buffer_load_dwordx4 v[84:87], v1, s[8:11], s41 offen offset:640 nt
    buffer_load_dwordx4 v[88:91], v1, s[8:11], s42 offen offset:0 nt
    buffer_load_dwordx4 v[92:95], v1, s[8:11], s42 offen offset:128 nt
    buffer_load_dwordx4 v[96:99], v1, s[8:11], s42 offen offset:512 nt
    buffer_load_dwordx4 v[100:103], v1, s[8:11], s42 offen offset:640 nt
    buffer_load_dwordx4 v[104:107], v1, s[8:11], s43 offen offset:0 nt
    buffer_load_dwordx4 v[108:111], v1, s[8:11], s43 offen offset:128 nt
    buffer_load_dwordx4 v[112:115], v1, s[8:11], s43 offen offset:512 nt
    buffer_load_dwordx4 v[116:119], v1, s[8:11], s43 offen offset:640 nt
    buffer_load_dwordx4 v[120:123], v1, s[8:11], s44 offen offset:0 nt
    buffer_load_dwordx4 v[124:127], v1, s[8:11], s44 offen offset:128 nt
    buffer_load_dwordx4 v[128:131], v1, s[8:11], s44 offen offset:512 nt
    buffer_load_dwordx4 v[132:135], v1, s[8:11], s44 offen offset:640 nt
    buffer_load_dwordx4 v[136:139], v1, s[8:11], s45 offen offset:0 nt
    buffer_load_dwordx4 v[140:143], v1, s[8:11], s45 offen offset:128 nt
    buffer_load_dwordx4 v[144:147], v1, s[8:11], s45 offen offset:512 nt
    buffer_load_dwordx4 v[148:151], v1, s[8:11], s45 offen offset:640 nt
    buffer_load_dwordx4 v[152:155], v1, s[8:11], s46 offen offset:0 nt
    buffer_load_dwordx4 v[156:159], v1, s[8:11], s46 offen offset:128 nt
    buffer_load_dwordx4 v[160:163], v1, s[8:11], s46 offen offset:512 nt
    buffer_load_dwordx4 v[164:167], v1, s[8:11], s46 offen offset:640 nt
    buffer_load_dwordx4 v[168:171], v1, s[8:11], s47 offen offset:0 nt
    buffer_load_dwordx4 v[172:175], v1, s[8:11], s47 offen offset:128 nt
    buffer_load_dwordx4 v[176:179], v1, s[8:11], s47 offen offset:512 nt
    buffer_load_dwordx4 v[180:183], v1, s[8:11], s47 offen offset:640 nt
    s_load_dwordx2 s[4:5], s[0:1], 0
    s_load_dwordx2 s[20:21], s[0:1], 40
    s_load_dwordx2 s[12:13], s[0:1], 16
    s_load_dwordx2 s[16:17], s[0:1], 24
    v_and_b32 v3, 7, v0
    v_lshl_add_u32 v3, v3, 8, v4
    s_movk_i32 s6, 0x4000
    s_mov_b32 s7, s11
    s_lshl_b32 s22, 1, 28
    s_mov_b32 s23, s11
    s_lshl_b32 s35, s25, 11
    s_lshl_b32 s36, s25, 7
    s_bitset1_b32 s36, 21
    s_waitcnt lgkmcnt(0)
    buffer_load_dwordx4 v[8:11], v3, s[4:7], s35 offen offset:0
    buffer_load_dwordx4 v[12:15], v3, s[4:7], s35 offen offset:128
    buffer_load_dword v255, off, s[20:23], s36 sc1
    s_setprio 0
    v_and_b32 v2, 63, v0
    v_lshlrev_b32 v2, 4, v2
    s_lshr_b32 s24, s24, 6
    s_mov_b32 s14, 0x4000000
    s_mov_b32 s15, 0x20000
    s_mov_b32 s18, 0x4000
    s_mov_b32 s19, 0x20000
    s_lshl_b32 s37, s25, 18
    s_lshl_b32 s31, s26, 13
    s_add_u32 s37, s37, s31
    s_getreg_b32 s38, hwreg(HW_REG_XCC_ID, 0, 4)
    s_mov_b32 s27, 0x3e0293ee
    s_mov_b32 s28, 0x05040100
    s_mov_b32 s29, 0x07060302
    s_mov_b32 s30, 0xff61b1e6
    v_and_b32 v4, 7, v0
    s_lshl_b32 s31, s24, 3
    v_lshl_add_u32 v5, v4, 6, s31
    v_and_b32 v1, 15, v0
    v_mul_u32_u24 v1, 528, v1
    v_bfe_u32 v4, v0, 4, 2
    v_lshl_add_u32 v1, v4, 7, v1
    s_lshl_b32 s31, s24, 12
    v_add_u32 v1, s31, v1
    s_waitcnt vmcnt(0)
    v_mfma_f32_16x16x32_bf16 v[24:27], v[56:59], v[8:11], 0
    v_mfma_f32_16x16x32_bf16 v[16:19], v[64:67], v[8:11], 0
    v_mfma_f32_16x16x32_bf16 v[24:27], v[60:63], v[12:15], v[24:27]
    v_mfma_f32_16x16x32_bf16 v[16:19], v[68:71], v[12:15], v[16:19]
    s_mov_b32 s31, 0x9E3779B1
    v_mul_lo_u32 v255, v255, s31
    v_add_u32 v255, 0x7F4A7C15, v255
    v_mfma_f32_16x16x32_bf16 v[28:31], v[72:75], v[8:11], 0
    v_mfma_f32_16x16x32_bf16 v[20:23], v[80:83], v[8:11], 0
    v_mfma_f32_16x16x32_bf16 v[28:31], v[76:79], v[12:15], v[28:31]
    v_mfma_f32_16x16x32_bf16 v[20:23], v[84:87], v[12:15], v[20:23]
    s_nop 3
    v_permlane32_swap_b32 v24, v16
    v_permlane32_swap_b32 v25, v17
    v_permlane32_swap_b32 v26, v18
    v_permlane32_swap_b32 v27, v19
    s_nop 0
    v_add_f32_dpp v24, v16, v24 row_ror:8 row_mask:0xf bank_mask:0xf
    v_add_f32_dpp v25, v17, v25 row_ror:8 row_mask:0xf bank_mask:0xf
    v_add_f32_dpp v26, v18, v26 row_ror:8 row_mask:0xf bank_mask:0xf
    v_add_f32_dpp v27, v19, v27 row_ror:8 row_mask:0xf bank_mask:0xf
    v_mfma_f32_16x16x32_bf16 v[32:35], v[88:91], v[8:11], 0
    v_mfma_f32_16x16x32_bf16 v[16:19], v[96:99], v[8:11], 0
    v_mfma_f32_16x16x32_bf16 v[32:35], v[92:95], v[12:15], v[32:35]
    v_mfma_f32_16x16x32_bf16 v[16:19], v[100:103], v[12:15], v[16:19]
    s_nop 3
    v_permlane32_swap_b32 v28, v20
    v_permlane32_swap_b32 v29, v21
    v_permlane32_swap_b32 v30, v22
    v_permlane32_swap_b32 v31, v23
    s_nop 0
    v_add_f32_dpp v28, v20, v28 row_ror:8 row_mask:0xf bank_mask:0xf
    v_add_f32_dpp v29, v21, v29 row_ror:8 row_mask:0xf bank_mask:0xf
    v_add_f32_dpp v30, v22, v30 row_ror:8 row_mask:0xf bank_mask:0xf
    v_add_f32_dpp v31, v23, v31 row_ror:8 row_mask:0xf bank_mask:0xf
    v_mfma_f32_16x16x32_bf16 v[36:39], v[104:107], v[8:11], 0
    v_mfma_f32_16x16x32_bf16 v[20:23], v[112:115], v[8:11], 0
    v_mfma_f32_16x16x32_bf16 v[36:39], v[108:111], v[12:15], v[36:39]
    v_mfma_f32_16x16x32_bf16 v[20:23], v[116:119], v[12:15], v[20:23]
    s_nop 3
    v_permlane32_swap_b32 v32, v16
    v_permlane32_swap_b32 v33, v17
    v_permlane32_swap_b32 v34, v18
    v_permlane32_swap_b32 v35, v19
    s_nop 0
    v_add_f32_dpp v32, v16, v32 row_ror:8 row_mask:0xf bank_mask:0xf
    v_add_f32_dpp v33, v17, v33 row_ror:8 row_mask:0xf bank_mask:0xf
    v_add_f32_dpp v34, v18, v34 row_ror:8 row_mask:0xf bank_mask:0xf
    v_add_f32_dpp v35, v19, v35 row_ror:8 row_mask:0xf bank_mask:0xf
    v_mfma_f32_16x16x32_bf16 v[40:43], v[120:123], v[8:11], 0
    v_mfma_f32_16x16x32_bf16 v[16:19], v[128:131], v[8:11], 0
    v_mfma_f32_16x16x32_bf16 v[40:43], v[124:127], v[12:15], v[40:43]
    v_mfma_f32_16x16x32_bf16 v[16:19], v[132:135], v[12:15], v[16:19]
    s_nop 3
    v_permlane32_swap_b32 v36, v20
    v_permlane32_swap_b32 v37, v21
    v_permlane32_swap_b32 v38, v22
    v_permlane32_swap_b32 v39, v23
    s_nop 0
    v_add_f32_dpp v36, v20, v36 row_ror:8 row_mask:0xf bank_mask:0xf
    v_add_f32_dpp v37, v21, v37 row_ror:8 row_mask:0xf bank_mask:0xf
    v_add_f32_dpp v38, v22, v38 row_ror:8 row_mask:0xf bank_mask:0xf
    v_add_f32_dpp v39, v23, v39 row_ror:8 row_mask:0xf bank_mask:0xf
    v_mfma_f32_16x16x32_bf16 v[44:47], v[136:139], v[8:11], 0
    v_mfma_f32_16x16x32_bf16 v[20:23], v[144:147], v[8:11], 0
    v_mfma_f32_16x16x32_bf16 v[44:47], v[140:143], v[12:15], v[44:47]
    v_mfma_f32_16x16x32_bf16 v[20:23], v[148:151], v[12:15], v[20:23]
    s_nop 3
    v_permlane32_swap_b32 v40, v16
    v_permlane32_swap_b32 v41, v17
    v_permlane32_swap_b32 v42, v18
    v_permlane32_swap_b32 v43, v19
    s_nop 0
    v_add_f32_dpp v40, v16, v40 row_ror:8 row_mask:0xf bank_mask:0xf
    v_add_f32_dpp v41, v17, v41 row_ror:8 row_mask:0xf bank_mask:0xf
    v_add_f32_dpp v42, v18, v42 row_ror:8 row_mask:0xf bank_mask:0xf
    v_add_f32_dpp v43, v19, v43 row_ror:8 row_mask:0xf bank_mask:0xf
    v_mfma_f32_16x16x32_bf16 v[48:51], v[152:155], v[8:11], 0
    v_mfma_f32_16x16x32_bf16 v[16:19], v[160:163], v[8:11], 0
    v_mfma_f32_16x16x32_bf16 v[48:51], v[156:159], v[12:15], v[48:51]
    v_mfma_f32_16x16x32_bf16 v[16:19], v[164:167], v[12:15], v[16:19]
    s_nop 3
    v_permlane32_swap_b32 v44, v20
    v_permlane32_swap_b32 v45, v21
    v_permlane32_swap_b32 v46, v22
    v_permlane32_swap_b32 v47, v23
    s_nop 0
    v_add_f32_dpp v44, v20, v44 row_ror:8 row_mask:0xf bank_mask:0xf
    v_add_f32_dpp v45, v21, v45 row_ror:8 row_mask:0xf bank_mask:0xf
    v_add_f32_dpp v46, v22, v46 row_ror:8 row_mask:0xf bank_mask:0xf
    v_add_f32_dpp v47, v23, v47 row_ror:8 row_mask:0xf bank_mask:0xf
    v_mfma_f32_16x16x32_bf16 v[52:55], v[168:171], v[8:11], 0
    v_mfma_f32_16x16x32_bf16 v[20:23], v[176:179], v[8:11], 0
    v_mfma_f32_16x16x32_bf16 v[52:55], v[172:175], v[12:15], v[52:55]
    v_mfma_f32_16x16x32_bf16 v[20:23], v[180:183], v[12:15], v[20:23]
    buffer_load_dwordx4 v[184:187], v2, s[12:15], s40 offen offset:0 nt
    buffer_load_dwordx4 v[188:191], v2, s[12:15], s40 offen offset:1024 nt
    buffer_load_dwordx4 v[192:195], v2, s[12:15], s40 offen offset:2048 nt
    buffer_load_dwordx4 v[196:199], v2, s[12:15], s40 offen offset:3072 nt
    buffer_load_dwordx4 v[200:203], v2, s[12:15], s41 offen offset:0 nt
    buffer_load_dwordx4 v[204:207], v2, s[12:15], s41 offen offset:1024 nt
    buffer_load_dwordx4 v[208:211], v2, s[12:15], s41 offen offset:2048 nt
    buffer_load_dwordx4 v[212:215], v2, s[12:15], s41 offen offset:3072 nt
    buffer_load_dwordx4 v[216:219], v2, s[12:15], s42 offen offset:0 nt
    buffer_load_dwordx4 v[220:223], v2, s[12:15], s42 offen offset:1024 nt
    buffer_load_dwordx4 v[224:227], v2, s[12:15], s42 offen offset:2048 nt
    buffer_load_dwordx4 v[228:231], v2, s[12:15], s42 offen offset:3072 nt
    buffer_load_dwordx4 v[232:235], v2, s[12:15], s43 offen offset:0 nt
    buffer_load_dwordx4 v[236:239], v2, s[12:15], s43 offen offset:1024 nt
    buffer_load_dwordx4 v[240:243], v2, s[12:15], s43 offen offset:2048 nt
    buffer_load_dwordx4 v[244:247], v2, s[12:15], s43 offen offset:3072 nt
    buffer_load_dwordx4 v[248:251], v2, s[12:15], s44 offen offset:0 nt
    buffer_load_dwordx4 v[56:59], v2, s[12:15], s44 offen offset:1024 nt
    buffer_load_dwordx4 v[60:63], v2, s[12:15], s44 offen offset:2048 nt
    buffer_load_dwordx4 v[64:67], v2, s[12:15], s44 offen offset:3072 nt
    buffer_load_dwordx4 v[68:71], v2, s[12:15], s45 offen offset:0 nt
    buffer_load_dwordx4 v[72:75], v2, s[12:15], s45 offen offset:1024 nt
    buffer_load_dwordx4 v[76:79], v2, s[12:15], s45 offen offset:2048 nt
    buffer_load_dwordx4 v[80:83], v2, s[12:15], s45 offen offset:3072 nt
    buffer_load_dwordx4 v[84:87], v2, s[12:15], s46 offen offset:0 nt
    buffer_load_dwordx4 v[88:91], v2, s[12:15], s46 offen offset:1024 nt
    buffer_load_dwordx4 v[92:95], v2, s[12:15], s46 offen offset:2048 nt
    buffer_load_dwordx4 v[96:99], v2, s[12:15], s46 offen offset:3072 nt
    buffer_load_dwordx4 v[100:103], v2, s[12:15], s47 offen offset:0 nt
    buffer_load_dwordx4 v[104:107], v2, s[12:15], s47 offen offset:1024 nt
    buffer_load_dwordx4 v[108:111], v2, s[12:15], s47 offen offset:2048 nt
    buffer_load_dwordx4 v[112:115], v2, s[12:15], s47 offen offset:3072 nt
    v_permlane32_swap_b32 v48, v16
    v_permlane32_swap_b32 v49, v17
    v_permlane32_swap_b32 v50, v18
    v_permlane32_swap_b32 v51, v19
    s_nop 0
    v_add_f32_dpp v48, v16, v48 row_ror:8 row_mask:0xf bank_mask:0xf
    v_add_f32_dpp v49, v17, v49 row_ror:8 row_mask:0xf bank_mask:0xf
    v_add_f32_dpp v50, v18, v50 row_ror:8 row_mask:0xf bank_mask:0xf
    v_add_f32_dpp v51, v19, v51 row_ror:8 row_mask:0xf bank_mask:0xf
    v_permlane32_swap_b32 v52, v20
    v_permlane32_swap_b32 v53, v21
    v_permlane32_swap_b32 v54, v22
    v_permlane32_swap_b32 v55, v23
    s_nop 0
    v_add_f32_dpp v52, v20, v52 row_ror:8 row_mask:0xf bank_mask:0xf
    v_add_f32_dpp v53, v21, v53 row_ror:8 row_mask:0xf bank_mask:0xf
    v_add_f32_dpp v54, v22, v54 row_ror:8 row_mask:0xf bank_mask:0xf
    v_add_f32_dpp v55, v23, v55 row_ror:8 row_mask:0xf bank_mask:0xf
    v_max3_f32 v6, v24, v25, s30
    v_max3_f32 v7, v26, v27, s30
    v_max3_f32 v6, v6, v28, v29
    v_max3_f32 v7, v7, v30, v31
    v_max3_f32 v6, v6, v32, v33
    v_max3_f32 v7, v7, v34, v35
    v_max3_f32 v6, v6, v36, v37
    v_max3_f32 v7, v7, v38, v39
    v_max3_f32 v6, v6, v40, v41
    v_max3_f32 v7, v7, v42, v43
    v_max3_f32 v6, v6, v44, v45
    v_max3_f32 v7, v7, v46, v47
    v_max3_f32 v6, v6, v48, v49
    v_max3_f32 v7, v7, v50, v51
    v_max3_f32 v6, v6, v52, v53
    v_max3_f32 v7, v7, v54, v55
    v_max_f32 v6, v6, v7
    v_mov_b32 v7, v6
    s_nop 1
    v_permlane32_swap_b32 v7, v6
    v_max_f32 v6, v6, v7
    v_mov_b32 v7, v6
    s_nop 1
    v_permlane16_swap_b32 v7, v6
    v_max_f32 v6, v6, v7
    v_mul_f32 v6, s27, v6
    v_fma_f32 v24, v24, s27, -v6
    v_fma_f32 v25, v25, s27, -v6
    v_fma_f32 v26, v26, s27, -v6
    v_fma_f32 v27, v27, s27, -v6
    v_fma_f32 v28, v28, s27, -v6
    v_fma_f32 v29, v29, s27, -v6
    v_fma_f32 v30, v30, s27, -v6
    v_fma_f32 v31, v31, s27, -v6
    v_fma_f32 v32, v32, s27, -v6
    v_fma_f32 v33, v33, s27, -v6
    v_fma_f32 v34, v34, s27, -v6
    v_fma_f32 v35, v35, s27, -v6
    v_fma_f32 v36, v36, s27, -v6
    v_fma_f32 v37, v37, s27, -v6
    v_fma_f32 v38, v38, s27, -v6
    v_fma_f32 v39, v39, s27, -v6
    v_fma_f32 v40, v40, s27, -v6
    v_fma_f32 v41, v41, s27, -v6
    v_fma_f32 v42, v42, s27, -v6
    v_fma_f32 v43, v43, s27, -v6
    v_fma_f32 v44, v44, s27, -v6
    v_fma_f32 v45, v45, s27, -v6
    v_fma_f32 v46, v46, s27, -v6
    v_fma_f32 v47, v47, s27, -v6
    v_fma_f32 v48, v48, s27, -v6
    v_fma_f32 v49, v49, s27, -v6
    v_fma_f32 v50, v50, s27, -v6
    v_fma_f32 v51, v51, s27, -v6
    v_fma_f32 v52, v52, s27, -v6
    v_fma_f32 v53, v53, s27, -v6
    v_fma_f32 v54, v54, s27, -v6
    v_fma_f32 v55, v55, s27, -v6
    v_exp_f32 v24, v24
    v_exp_f32 v25, v25
    v_exp_f32 v26, v26
    v_exp_f32 v27, v27
    v_exp_f32 v28, v28
    v_exp_f32 v29, v29
    v_exp_f32 v30, v30
    v_exp_f32 v31, v31
    v_exp_f32 v32, v32
    v_exp_f32 v33, v33
    v_exp_f32 v34, v34
    v_exp_f32 v35, v35
    v_exp_f32 v36, v36
    v_exp_f32 v37, v37
    v_exp_f32 v38, v38
    v_exp_f32 v39, v39
    v_exp_f32 v40, v40
    v_exp_f32 v41, v41
    v_exp_f32 v42, v42
    v_exp_f32 v43, v43
    v_exp_f32 v44, v44
    v_exp_f32 v45, v45
    v_exp_f32 v46, v46
    v_exp_f32 v47, v47
    v_exp_f32 v48, v48
    v_exp_f32 v49, v49
    v_exp_f32 v50, v50
    v_exp_f32 v51, v51
    v_exp_f32 v52, v52
    v_exp_f32 v53, v53
    v_exp_f32 v54, v54
    v_exp_f32 v55, v55
    v_add_f32 v7, v24, v25
    v_add_f32 v148, v26, v27
    v_add_f32 v7, v7, v28
    v_add_f32 v148, v148, v29
    v_add_f32 v7, v7, v30
    v_add_f32 v148, v148, v31
    v_add_f32 v7, v7, v32
    v_add_f32 v148, v148, v33
    v_add_f32 v7, v7, v34
    v_add_f32 v148, v148, v35
    v_add_f32 v7, v7, v36
    v_add_f32 v148, v148, v37
    v_add_f32 v7, v7, v38
    v_add_f32 v148, v148, v39
    v_add_f32 v7, v7, v40
    v_add_f32 v148, v148, v41
    v_add_f32 v7, v7, v42
    v_add_f32 v148, v148, v43
    v_add_f32 v7, v7, v44
    v_add_f32 v148, v148, v45
    v_add_f32 v7, v7, v46
    v_add_f32 v148, v148, v47
    v_add_f32 v7, v7, v48
    v_add_f32 v148, v148, v49
    v_add_f32 v7, v7, v50
    v_add_f32 v148, v148, v51
    v_add_f32 v7, v7, v52
    v_add_f32 v148, v148, v53
    v_add_f32 v7, v7, v54
    v_add_f32 v148, v148, v55
    v_add_f32 v7, v7, v148
    v_mov_b32 v148, v7
    v_cvt_pk_bf16_f32 v24, v24, v25
    v_cvt_pk_bf16_f32 v25, v26, v27
    v_cvt_pk_bf16_f32 v26, v28, v29
    v_cvt_pk_bf16_f32 v27, v30, v31
    v_cvt_pk_bf16_f32 v32, v32, v33
    v_cvt_pk_bf16_f32 v33, v34, v35
    v_cvt_pk_bf16_f32 v34, v36, v37
    v_cvt_pk_bf16_f32 v35, v38, v39
    v_cvt_pk_bf16_f32 v40, v40, v41
    v_cvt_pk_bf16_f32 v41, v42, v43
    v_cvt_pk_bf16_f32 v42, v44, v45
    v_cvt_pk_bf16_f32 v43, v46, v47
    v_cvt_pk_bf16_f32 v48, v48, v49
    v_cvt_pk_bf16_f32 v49, v50, v51
    v_cvt_pk_bf16_f32 v50, v52, v53
    v_cvt_pk_bf16_f32 v51, v54, v55
    v_permlane32_swap_b32 v148, v7
    v_add_f32 v7, v7, v148
    v_mov_b32 v148, v7
    s_nop 1
    v_permlane16_swap_b32 v148, v7
    v_add_f32 v7, v7, v148
    s_mov_b64 exec, 0xff
    ds_write_b64 v5, v[6:7] offset:0
    s_mov_b64 exec, -1
    v_xor_b32 v28, 0, v1
    v_xor_b32 v29, 16, v1
    v_xor_b32 v30, 32, v1
    v_xor_b32 v31, 48, v1
    v_xor_b32 v36, 64, v1
    v_xor_b32 v37, 80, v1
    v_xor_b32 v38, 96, v1
    v_xor_b32 v39, 112, v1
    s_cmp_lt_u32 s24, 4
    s_cbranch_scc1 L_early
    s_and_b32 s31, s24, 3
    s_lshl_b32 s31, s31, 11
    s_add_u32 s31, s31, s37
    s_waitcnt lgkmcnt(0)
    s_barrier
    buffer_load_dword v253, v2, s[20:23], s31 offen
    buffer_load_dword v254, v2, s[20:23], s31 offen offset:1024
    s_branch L_pv
L_early:
    buffer_load_dword v253, off, s[20:23], s36
    buffer_load_dword v254, off, s[20:23], s36
L_pv:
    s_waitcnt vmcnt(26)
    v_perm_b32 v148, v188, v184, s28
    v_perm_b32 v149, v196, v192, s28
    v_perm_b32 v150, v204, v200, s28
    v_perm_b32 v151, v212, v208, s28
    v_perm_b32 v152, v188, v184, s29
    v_perm_b32 v153, v196, v192, s29
    v_perm_b32 v154, v204, v200, s29
    v_perm_b32 v155, v212, v208, s29
    v_mfma_f32_16x16x32_bf16 v[116:119], v[148:151], v[24:27], 0
    s_nop 0
    v_mfma_f32_16x16x32_bf16 v[120:123], v[152:155], v[24:27], 0
    v_perm_b32 v148, v189, v185, s28
    v_perm_b32 v149, v197, v193, s28
    v_perm_b32 v150, v205, v201, s28
    v_perm_b32 v151, v213, v209, s28
    v_perm_b32 v152, v189, v185, s29
    v_perm_b32 v153, v197, v193, s29
    v_perm_b32 v154, v205, v201, s29
    v_perm_b32 v155, v213, v209, s29
    v_mfma_f32_16x16x32_bf16 v[124:127], v[148:151], v[24:27], 0
    s_nop 0
    v_mfma_f32_16x16x32_bf16 v[128:131], v[152:155], v[24:27], 0
    v_perm_b32 v148, v190, v186, s28
    v_perm_b32 v149, v198, v194, s28
    v_perm_b32 v150, v206, v202, s28
    v_perm_b32 v151, v214, v210, s28
    v_perm_b32 v152, v190, v186, s29
    v_perm_b32 v153, v198, v194, s29
    v_perm_b32 v154, v206, v202, s29
    v_perm_b32 v155, v214, v210, s29
    v_mfma_f32_16x16x32_bf16 v[132:135], v[148:151], v[24:27], 0
    s_nop 0
    v_mfma_f32_16x16x32_bf16 v[136:139], v[152:155], v[24:27], 0
    v_perm_b32 v148, v191, v187, s28
    v_perm_b32 v149, v199, v195, s28
    v_perm_b32 v150, v207, v203, s28
    v_perm_b32 v151, v215, v211, s28
    v_perm_b32 v152, v191, v187, s29
    v_perm_b32 v153, v199, v195, s29
    v_perm_b32 v154, v207, v203, s29
    v_perm_b32 v155, v215, v211, s29
    v_mfma_f32_16x16x32_bf16 v[140:143], v[148:151], v[24:27], 0
    s_nop 0
    v_mfma_f32_16x16x32_bf16 v[144:147], v[152:155], v[24:27], 0
    s_waitcnt vmcnt(18)
    v_perm_b32 v148, v220, v216, s28
    v_perm_b32 v149, v228, v224, s28
    v_perm_b32 v150, v236, v232, s28
    v_perm_b32 v151, v244, v240, s28
    v_perm_b32 v152, v220, v216, s29
    v_perm_b32 v153, v228, v224, s29
    v_perm_b32 v154, v236, v232, s29
    v_perm_b32 v155, v244, v240, s29
    v_mfma_f32_16x16x32_bf16 v[116:119], v[148:151], v[32:35], v[116:119]
    s_nop 0
    v_mfma_f32_16x16x32_bf16 v[120:123], v[152:155], v[32:35], v[120:123]
    v_perm_b32 v148, v221, v217, s28
    v_perm_b32 v149, v229, v225, s28
    v_perm_b32 v150, v237, v233, s28
    v_perm_b32 v151, v245, v241, s28
    v_perm_b32 v152, v221, v217, s29
    v_perm_b32 v153, v229, v225, s29
    v_perm_b32 v154, v237, v233, s29
    v_perm_b32 v155, v245, v241, s29
    v_mfma_f32_16x16x32_bf16 v[124:127], v[148:151], v[32:35], v[124:127]
    s_nop 0
    v_mfma_f32_16x16x32_bf16 v[128:131], v[152:155], v[32:35], v[128:131]
    v_perm_b32 v148, v222, v218, s28
    v_perm_b32 v149, v230, v226, s28
    v_perm_b32 v150, v238, v234, s28
    v_perm_b32 v151, v246, v242, s28
    v_perm_b32 v152, v222, v218, s29
    v_perm_b32 v153, v230, v226, s29
    v_perm_b32 v154, v238, v234, s29
    v_perm_b32 v155, v246, v242, s29
    v_mfma_f32_16x16x32_bf16 v[132:135], v[148:151], v[32:35], v[132:135]
    s_nop 0
    v_mfma_f32_16x16x32_bf16 v[136:139], v[152:155], v[32:35], v[136:139]
    v_perm_b32 v148, v223, v219, s28
    v_perm_b32 v149, v231, v227, s28
    v_perm_b32 v150, v239, v235, s28
    v_perm_b32 v151, v247, v243, s28
    v_perm_b32 v152, v223, v219, s29
    v_perm_b32 v153, v231, v227, s29
    v_perm_b32 v154, v239, v235, s29
    v_perm_b32 v155, v247, v243, s29
    v_mfma_f32_16x16x32_bf16 v[140:143], v[148:151], v[32:35], v[140:143]
    s_nop 0
    v_mfma_f32_16x16x32_bf16 v[144:147], v[152:155], v[32:35], v[144:147]
    s_waitcnt vmcnt(10)
    v_perm_b32 v148, v56, v248, s28
    v_perm_b32 v149, v64, v60, s28
    v_perm_b32 v150, v72, v68, s28
    v_perm_b32 v151, v80, v76, s28
    v_perm_b32 v152, v56, v248, s29
    v_perm_b32 v153, v64, v60, s29
    v_perm_b32 v154, v72, v68, s29
    v_perm_b32 v155, v80, v76, s29
    v_mfma_f32_16x16x32_bf16 v[116:119], v[148:151], v[40:43], v[116:119]
    s_nop 0
    v_mfma_f32_16x16x32_bf16 v[120:123], v[152:155], v[40:43], v[120:123]
    v_perm_b32 v148, v57, v249, s28
    v_perm_b32 v149, v65, v61, s28
    v_perm_b32 v150, v73, v69, s28
    v_perm_b32 v151, v81, v77, s28
    v_perm_b32 v152, v57, v249, s29
    v_perm_b32 v153, v65, v61, s29
    v_perm_b32 v154, v73, v69, s29
    v_perm_b32 v155, v81, v77, s29
    v_mfma_f32_16x16x32_bf16 v[124:127], v[148:151], v[40:43], v[124:127]
    s_nop 0
    v_mfma_f32_16x16x32_bf16 v[128:131], v[152:155], v[40:43], v[128:131]
    v_perm_b32 v148, v58, v250, s28
    v_perm_b32 v149, v66, v62, s28
    v_perm_b32 v150, v74, v70, s28
    v_perm_b32 v151, v82, v78, s28
    v_perm_b32 v152, v58, v250, s29
    v_perm_b32 v153, v66, v62, s29
    v_perm_b32 v154, v74, v70, s29
    v_perm_b32 v155, v82, v78, s29
    v_mfma_f32_16x16x32_bf16 v[132:135], v[148:151], v[40:43], v[132:135]
    s_nop 0
    v_mfma_f32_16x16x32_bf16 v[136:139], v[152:155], v[40:43], v[136:139]
    v_perm_b32 v148, v59, v251, s28
    v_perm_b32 v149, v67, v63, s28
    v_perm_b32 v150, v75, v71, s28
    v_perm_b32 v151, v83, v79, s28
    v_perm_b32 v152, v59, v251, s29
    v_perm_b32 v153, v67, v63, s29
    v_perm_b32 v154, v75, v71, s29
    v_perm_b32 v155, v83, v79, s29
    v_mfma_f32_16x16x32_bf16 v[140:143], v[148:151], v[40:43], v[140:143]
    s_nop 0
    v_mfma_f32_16x16x32_bf16 v[144:147], v[152:155], v[40:43], v[144:147]
    s_waitcnt vmcnt(2)
    v_perm_b32 v148, v88, v84, s28
    v_perm_b32 v149, v96, v92, s28
    v_perm_b32 v150, v104, v100, s28
    v_perm_b32 v151, v112, v108, s28
    v_perm_b32 v152, v88, v84, s29
    v_perm_b32 v153, v96, v92, s29
    v_perm_b32 v154, v104, v100, s29
    v_perm_b32 v155, v112, v108, s29
    v_mfma_f32_16x16x32_bf16 v[116:119], v[148:151], v[48:51], v[116:119]
    s_nop 0
    v_mfma_f32_16x16x32_bf16 v[120:123], v[152:155], v[48:51], v[120:123]
    v_perm_b32 v148, v89, v85, s28
    v_perm_b32 v149, v97, v93, s28
    v_perm_b32 v150, v105, v101, s28
    v_perm_b32 v151, v113, v109, s28
    v_perm_b32 v152, v89, v85, s29
    v_perm_b32 v153, v97, v93, s29
    v_perm_b32 v154, v105, v101, s29
    v_perm_b32 v155, v113, v109, s29
    v_mfma_f32_16x16x32_bf16 v[124:127], v[148:151], v[48:51], v[124:127]
    s_nop 0
    v_mfma_f32_16x16x32_bf16 v[128:131], v[152:155], v[48:51], v[128:131]
    v_perm_b32 v148, v90, v86, s28
    v_perm_b32 v149, v98, v94, s28
    v_perm_b32 v150, v106, v102, s28
    v_perm_b32 v151, v114, v110, s28
    v_perm_b32 v152, v90, v86, s29
    v_perm_b32 v153, v98, v94, s29
    v_perm_b32 v154, v106, v102, s29
    v_perm_b32 v155, v114, v110, s29
    v_mfma_f32_16x16x32_bf16 v[132:135], v[148:151], v[48:51], v[132:135]
    s_nop 0
    v_mfma_f32_16x16x32_bf16 v[136:139], v[152:155], v[48:51], v[136:139]
    v_perm_b32 v148, v91, v87, s28
    v_perm_b32 v149, v99, v95, s28
    v_perm_b32 v150, v107, v103, s28
    v_perm_b32 v151, v115, v111, s28
    v_perm_b32 v152, v91, v87, s29
    v_perm_b32 v153, v99, v95, s29
    v_perm_b32 v154, v107, v103, s29
    v_perm_b32 v155, v115, v111, s29
    v_mfma_f32_16x16x32_bf16 v[140:143], v[148:151], v[48:51], v[140:143]
    s_nop 0
    v_mfma_f32_16x16x32_bf16 v[144:147], v[152:155], v[48:51], v[144:147]
    s_mov_b32 exec_lo, 0x00ff00ff
    s_mov_b32 exec_hi, 0x00ff00ff
    ds_write_b128 v28, v[116:119] offset:1024
    ds_write_b128 v29, v[120:123] offset:1024
    ds_write_b128 v30, v[124:127] offset:1024
    ds_write_b128 v31, v[128:131] offset:1024
    ds_write_b128 v36, v[132:135] offset:1024
    ds_write_b128 v37, v[136:139] offset:1024
    ds_write_b128 v38, v[140:143] offset:1024
    ds_write_b128 v39, v[144:147] offset:1024
    s_mov_b64 exec, -1
    s_waitcnt lgkmcnt(0)
    s_barrier
    s_cmp_ge_u32 s24, 4
    s_cbranch_scc1 L_late
    v_lshrrev_b32 v4, 5, v0
    v_lshlrev_b32 v7, 6, v4
    ds_read_b128 v[8:11], v7 offset:0
    ds_read_b128 v[12:15], v7 offset:16
    ds_read_b128 v[16:19], v7 offset:32
    ds_read_b128 v[20:23], v7 offset:48
    v_xor_b32 v5, v4, v0
    v_and_b32 v5, 7, v5
    v_lshrrev_b32 v1, 3, v0
    v_lshlrev_b32 v7, 7, v1
    v_lshl_add_u32 v5, v5, 4, v7
    ds_read_b128 v[24:27], v5 offset:1024
    ds_read_b128 v[28:31], v5 offset:5120
    ds_read_b128 v[32:35], v5 offset:9216
    ds_read_b128 v[36:39], v5 offset:13312
    v_and_b32 v4, 7, v0
    v_lshlrev_b32 v4, 4, v4
    v_lshl_add_u32 v4, v1, 13, v4
    v_lshlrev_b32 v3, 4, v0
    s_lshl_b32 s31, s25, 18
    s_lshl_b32 s32, s26, 7
    s_add_u32 s31, s31, s32
    s_add_u32 s32, s31, 4096
    s_waitcnt lgkmcnt(4)
    v_max3_f32 v6, v8, v10, v12
    v_max3_f32 v6, v6, v14, v16
    v_max3_f32 v6, v6, v18, v20
    v_max_f32 v62, v6, v22
    v_sub_f32 v8, v8, v62
    v_sub_f32 v10, v10, v62
    v_sub_f32 v12, v12, v62
    v_sub_f32 v14, v14, v62
    v_sub_f32 v16, v16, v62
    v_sub_f32 v18, v18, v62
    v_sub_f32 v20, v20, v62
    v_sub_f32 v22, v22, v62
    v_exp_f32 v8, v8
    v_exp_f32 v10, v10
    v_exp_f32 v12, v12
    v_exp_f32 v14, v14
    v_exp_f32 v16, v16
    v_exp_f32 v18, v18
    v_exp_f32 v20, v20
    v_exp_f32 v22, v22
    v_mov_b32 v63, v255
    v_mul_f32 v7, v8, v9
    v_fmac_f32 v7, v10, v11
    v_fmac_f32 v7, v12, v13
    v_fmac_f32 v7, v14, v15
    v_fmac_f32 v7, v16, v17
    v_fmac_f32 v7, v18, v19
    v_fmac_f32 v7, v20, v21
    v_fmac_f32 v7, v22, v23
    v_and_b32 v66, -16, v7
    v_or_b32 v66, s38, v66
    v_mov_b32 v67, v255
    s_waitcnt lgkmcnt(0)
    v_pk_mul_f32 v[60:61], v[24:25], v[8:9] op_sel_hi:[1,0]
    v_pk_mul_f32 v[64:65], v[26:27], v[8:9] op_sel_hi:[1,0]
    v_pk_fma_f32 v[60:61], v[28:29], v[10:11], v[60:61] op_sel_hi:[1,0,1]
    v_pk_fma_f32 v[64:65], v[30:31], v[10:11], v[64:65] op_sel_hi:[1,0,1]
    v_pk_fma_f32 v[60:61], v[32:33], v[12:13], v[60:61] op_sel_hi:[1,0,1]
    v_pk_fma_f32 v[64:65], v[34:35], v[12:13], v[64:65] op_sel_hi:[1,0,1]
    v_pk_fma_f32 v[60:61], v[36:37], v[14:15], v[60:61] op_sel_hi:[1,0,1]
    v_pk_fma_f32 v[64:65], v[38:39], v[14:15], v[64:65] op_sel_hi:[1,0,1]
    s_barrier
    ds_read_b128 v[40:43], v5 offset:17408
    ds_read_b128 v[44:47], v5 offset:21504
    ds_read_b128 v[48:51], v5 offset:25600
    ds_read_b128 v[52:55], v5 offset:29696
    s_waitcnt lgkmcnt(3)
    v_pk_fma_f32 v[60:61], v[40:41], v[16:17], v[60:61] op_sel_hi:[1,0,1]
    v_pk_fma_f32 v[64:65], v[42:43], v[16:17], v[64:65] op_sel_hi:[1,0,1]
    s_waitcnt lgkmcnt(2)
    v_pk_fma_f32 v[60:61], v[44:45], v[18:19], v[60:61] op_sel_hi:[1,0,1]
    v_pk_fma_f32 v[64:65], v[46:47], v[18:19], v[64:65] op_sel_hi:[1,0,1]
    s_waitcnt lgkmcnt(1)
    v_pk_fma_f32 v[60:61], v[48:49], v[20:21], v[60:61] op_sel_hi:[1,0,1]
    v_pk_fma_f32 v[64:65], v[50:51], v[20:21], v[64:65] op_sel_hi:[1,0,1]
    s_waitcnt lgkmcnt(0)
    v_pk_fma_f32 v[60:61], v[52:53], v[22:23], v[60:61] op_sel_hi:[1,0,1]
    v_pk_fma_f32 v[64:65], v[54:55], v[22:23], v[64:65] op_sel_hi:[1,0,1]
    buffer_store_dwordx4 v[60:63], v4, s[20:23], s31 offen
    buffer_store_dwordx4 v[64:67], v4, s[20:23], s32 offen
    ds_write_b128 v3, v[60:63] offset:1024
    ds_write_b128 v3, v[64:67] offset:5120
    s_waitcnt lgkmcnt(0)
    s_branch L_done
L_late:
    s_cmp_lg_u32 s24, 4
    s_cbranch_scc1 L_done
    s_add_u32 s32, s37, 4096
    s_mov_b32 s34, 0
L_poll:
    buffer_load_dwordx4 v[16:19], v2, s[20:23], s37 offen offset:0 sc1
    buffer_load_dwordx4 v[20:23], v2, s[20:23], s32 offen offset:0 sc1
    buffer_load_dwordx4 v[24:27], v2, s[20:23], s37 offen offset:1024 sc1
    buffer_load_dwordx4 v[28:31], v2, s[20:23], s32 offen offset:1024 sc1
    buffer_load_dwordx4 v[32:35], v2, s[20:23], s37 offen offset:2048 sc1
    buffer_load_dwordx4 v[36:39], v2, s[20:23], s32 offen offset:2048 sc1
    buffer_load_dwordx4 v[40:43], v2, s[20:23], s37 offen offset:3072 sc1
    buffer_load_dwordx4 v[44:47], v2, s[20:23], s32 offen offset:3072 sc1
    s_add_u32 s34, s34, 1
    v_and_b32 v8, 63, v0
    s_lshl_b32 s33, s26, 6
    s_add_u32 s33, s33, s35
    v_bfe_u32 v10, v0, 4, 1
    v_lshlrev_b32 v13, 5, v10
    v_bfe_u32 v10, v0, 5, 1
    v_lshl_add_u32 v13, v10, 4, v13
    v_and_b32 v10, 7, v0
    v_lshl_add_u32 v13, v10, 1, v13
    s_waitcnt vmcnt(6)
    v_cmpx_eq_u32 vcc, v255, v19
    v_cmpx_eq_u32 vcc, v255, v23
    s_waitcnt vmcnt(4)
    v_cmpx_eq_u32 vcc, v255, v27
    v_cmpx_eq_u32 vcc, v255, v31
    s_waitcnt vmcnt(2)
    v_cmpx_eq_u32 vcc, v255, v35
    v_cmpx_eq_u32 vcc, v255, v39
    s_waitcnt vmcnt(0)
    v_cmpx_eq_u32 vcc, v255, v43
    v_cmpx_eq_u32 vcc, v255, v47
    s_nop 3
    s_mov_b64 vcc, exec
    s_mov_b64 exec, -1
    s_cmp_eq_u64 vcc, -1
    s_cbranch_scc1 L_polled
    s_cmp_lt_u32 s34, 24
    s_cbranch_scc1 L_poll
    s_barrier
    v_lshlrev_b32 v56, 4, v8
    v_lshrrev_b32 v57, 3, v8
    v_lshlrev_b32 v57, 13, v57
    v_and_b32 v60, 7, v8
    v_lshl_add_u32 v57, v60, 4, v57
    s_lshl_b32 s48, s25, 18
    s_lshl_b32 s49, s26, 7
    s_add_u32 s48, s48, s49
    ds_read_b128 v[60:63], v56 offset:1024
    ds_read_b128 v[64:67], v56 offset:5120
    ds_read_b128 v[68:71], v56 offset:2048
    ds_read_b128 v[72:75], v56 offset:6144
    ds_read_b128 v[76:79], v56 offset:3072
    ds_read_b128 v[80:83], v56 offset:7168
    ds_read_b128 v[84:87], v56 offset:4096
    ds_read_b128 v[88:91], v56 offset:8192
    s_waitcnt lgkmcnt(0)
    s_add_u32 s49, s48, 4096
    buffer_store_dwordx4 v[60:63], v57, s[20:23], s48 offen sc1
    buffer_store_dwordx4 v[64:67], v57, s[20:23], s49 offen sc1
    s_add_u32 s48, s48, 0x10000
    s_add_u32 s49, s48, 4096
    buffer_store_dwordx4 v[68:71], v57, s[20:23], s48 offen sc1
    buffer_store_dwordx4 v[72:75], v57, s[20:23], s49 offen sc1
    s_add_u32 s48, s48, 0x10000
    s_add_u32 s49, s48, 4096
    buffer_store_dwordx4 v[76:79], v57, s[20:23], s48 offen sc1
    buffer_store_dwordx4 v[80:83], v57, s[20:23], s49 offen sc1
    s_add_u32 s48, s48, 0x10000
    s_add_u32 s49, s48, 4096
    buffer_store_dwordx4 v[84:87], v57, s[20:23], s48 offen sc1
    buffer_store_dwordx4 v[88:91], v57, s[20:23], s49 offen sc1
    s_add_u32 s48, s48, 0x10000
    s_waitcnt vmcnt(0)
L_pollfar:
    buffer_load_dwordx4 v[16:19], v2, s[20:23], s37 offen offset:0 sc1
    buffer_load_dwordx4 v[20:23], v2, s[20:23], s32 offen offset:0 sc1
    buffer_load_dwordx4 v[24:27], v2, s[20:23], s37 offen offset:1024 sc1
    buffer_load_dwordx4 v[28:31], v2, s[20:23], s32 offen offset:1024 sc1
    buffer_load_dwordx4 v[32:35], v2, s[20:23], s37 offen offset:2048 sc1
    buffer_load_dwordx4 v[36:39], v2, s[20:23], s32 offen offset:2048 sc1
    buffer_load_dwordx4 v[40:43], v2, s[20:23], s37 offen offset:3072 sc1
    buffer_load_dwordx4 v[44:47], v2, s[20:23], s32 offen offset:3072 sc1
    s_add_u32 s34, s34, 1
    s_waitcnt vmcnt(6)
    v_cmpx_eq_u32 vcc, v255, v19
    v_cmpx_eq_u32 vcc, v255, v23
    s_waitcnt vmcnt(4)
    v_cmpx_eq_u32 vcc, v255, v27
    v_cmpx_eq_u32 vcc, v255, v31
    s_waitcnt vmcnt(2)
    v_cmpx_eq_u32 vcc, v255, v35
    v_cmpx_eq_u32 vcc, v255, v39
    s_waitcnt vmcnt(0)
    v_cmpx_eq_u32 vcc, v255, v43
    v_cmpx_eq_u32 vcc, v255, v47
    s_nop 3
    s_mov_b64 vcc, exec
    s_mov_b64 exec, -1
    s_cmp_eq_u64 vcc, -1
    s_cbranch_scc1 L_polled
    s_bitcmp0_b32 s34, 20
    s_cbranch_scc1 L_pollfar
L_polled:
    v_max3_f32 v11, v18, v26, v34
    v_max_f32 v11, v11, v42
    s_nop 1
    v_max_f32_dpp v11, v11, v11 row_ror:8 row_mask:0xf bank_mask:0xf
    v_mov_b32 v10, v11
    s_nop 1
    v_permlane16_swap_b32 v10, v11
    v_max_f32 v11, v11, v10
    v_mov_b32 v10, v11
    s_nop 1
    v_permlane32_swap_b32 v10, v11
    v_max_f32 v11, v11, v10
    v_sub_f32 v48, v18, v11
    v_sub_f32 v49, v26, v11
    v_sub_f32 v50, v34, v11
    v_sub_f32 v51, v42, v11
    v_exp_f32 v48, v48
    v_exp_f32 v49, v49
    v_exp_f32 v50, v50
    v_exp_f32 v51, v51
    v_mul_f32 v12, v48, v22
    v_mul_f32 v52, v48, v16
    v_mul_f32 v53, v48, v17
    v_mul_f32 v54, v48, v20
    v_mul_f32 v55, v48, v21
    v_fmac_f32 v12, v49, v30
    v_fmac_f32 v52, v49, v24
    v_fmac_f32 v53, v49, v25
    v_fmac_f32 v54, v49, v28
    v_fmac_f32 v55, v49, v29
    v_fmac_f32 v12, v50, v38
    v_fmac_f32 v52, v50, v32
    v_fmac_f32 v53, v50, v33
    v_fmac_f32 v54, v50, v36
    v_fmac_f32 v55, v50, v37
    v_fmac_f32 v12, v51, v46
    v_fmac_f32 v52, v51, v40
    v_fmac_f32 v53, v51, v41
    v_fmac_f32 v54, v51, v44
    v_fmac_f32 v55, v51, v45
    v_mov_b32 v10, v12
    s_nop 0
    v_permlane32_swap_b32 v52, v53
    v_permlane32_swap_b32 v54, v55
    v_permlane32_swap_b32 v10, v12
    v_add_f32 v52, v52, v53
    v_add_f32 v54, v54, v55
    v_add_f32 v12, v12, v10
    v_mov_b32 v10, v12
    s_nop 1
    v_permlane16_swap_b32 v52, v54
    v_permlane16_swap_b32 v10, v12
    v_add_f32 v52, v52, v54
    v_add_f32 v12, v12, v10
    s_nop 1
    v_add_f32_dpp v12, v12, v12 row_ror:8 row_mask:0xf bank_mask:0xf
    v_add_f32_dpp v52, v52, v52 row_ror:8 row_mask:0xf bank_mask:0xf
    v_rcp_f32 v12, v12
    s_nop 0
    v_mul_f32 v52, v52, v12
    v_cvt_pk_bf16_f32 v52, v52, v52
    buffer_store_short v52, v13, s[16:19], s33 offen
    s_cmp_gt_u32 s34, 24
    s_cbranch_scc1 L_nearok
    v_and_b32 v48, 15, v22
    v_and_b32 v49, 15, v30
    v_and_b32 v50, 15, v38
    v_and_b32 v51, 15, v46
    v_cmpx_eq_u32 vcc, s38, v48
    v_cmpx_eq_u32 vcc, s38, v49
    v_cmpx_eq_u32 vcc, s38, v50
    v_cmpx_eq_u32 vcc, s38, v51
    s_nop 3
    s_mov_b64 vcc, exec
    s_mov_b64 exec, -1
    s_cmp_eq_u64 vcc, -1
    s_cbranch_scc1 L_nearok
    s_barrier
    v_lshlrev_b32 v56, 4, v8
    v_lshrrev_b32 v57, 3, v8
    v_lshlrev_b32 v57, 13, v57
    v_and_b32 v60, 7, v8
    v_lshl_add_u32 v57, v60, 4, v57
    s_lshl_b32 s48, s25, 18
    s_lshl_b32 s49, s26, 7
    s_add_u32 s48, s48, s49
    ds_read_b128 v[60:63], v56 offset:1024
    ds_read_b128 v[64:67], v56 offset:5120
    ds_read_b128 v[68:71], v56 offset:2048
    ds_read_b128 v[72:75], v56 offset:6144
    ds_read_b128 v[76:79], v56 offset:3072
    ds_read_b128 v[80:83], v56 offset:7168
    ds_read_b128 v[84:87], v56 offset:4096
    ds_read_b128 v[88:91], v56 offset:8192
    s_waitcnt lgkmcnt(0)
    s_add_u32 s49, s48, 4096
    buffer_store_dwordx4 v[60:63], v57, s[20:23], s48 offen sc1
    buffer_store_dwordx4 v[64:67], v57, s[20:23], s49 offen sc1
    s_add_u32 s48, s48, 0x10000
    s_add_u32 s49, s48, 4096
    buffer_store_dwordx4 v[68:71], v57, s[20:23], s48 offen sc1
    buffer_store_dwordx4 v[72:75], v57, s[20:23], s49 offen sc1
    s_add_u32 s48, s48, 0x10000
    s_add_u32 s49, s48, 4096
    buffer_store_dwordx4 v[76:79], v57, s[20:23], s48 offen sc1
    buffer_store_dwordx4 v[80:83], v57, s[20:23], s49 offen sc1
    s_add_u32 s48, s48, 0x10000
    s_add_u32 s49, s48, 4096
    buffer_store_dwordx4 v[84:87], v57, s[20:23], s48 offen sc1
    buffer_store_dwordx4 v[88:91], v57, s[20:23], s49 offen sc1
    s_add_u32 s48, s48, 0x10000
L_nearok:
    s_cmp_lg_u32 s26, 0
    s_cbranch_scc1 L_done
    s_mov_b64 exec, 1
    buffer_store_dword v255, off, s[20:23], s36 sc1
    s_mov_b64 exec, -1
L_done:
L_end:
    s_endpgm
.section .rodata,"a"
.p2align 6
.amdhsa_kernel standalone__gqa_softmax__decode_kernel
  .amdhsa_next_free_vgpr 256
  .amdhsa_next_free_sgpr 56
  .amdhsa_accum_offset 256
  .amdhsa_group_segment_fixed_size 0
  .amdhsa_kernarg_size 48
  .amdhsa_user_sgpr_count 2
  .amdhsa_user_sgpr_kernarg_segment_ptr 1
  .amdhsa_system_sgpr_workgroup_id_x 1
  .amdhsa_float_denorm_mode_32 3
.end_amdhsa_kernel
```
